```python
import torch

def _softmax(x, axis=-1):
    return torch.softmax(x, dim=axis)

def _gelu(x):
    return torch.nn.functional.gelu(x, approximate='tanh')

def _silu(x):
    return torch.nn.functional.silu(x)

def _sigmoid(x):
    return torch.sigmoid(x)

def _layernorm(x, axis=-1, eps=1e-05):
    m = x.mean(dim=axis, keepdim=True)
    v = x.var(dim=axis, keepdim=True, unbiased=False)
    return (x - m) / torch.sqrt(v + eps)

def _scatter_add(tgt, idx, src, axis=0):
    return tgt.clone().index_add_(axis, idx, src)

def _segment_sum(src, seg, n):
    out = torch.zeros((n,) + src.shape[1:], dtype=src.dtype)
    return out.index_add_(0, seg, src)

def _pad(x, pw):
    flat = tuple((v for pair in reversed(pw) for v in pair))
    return torch.nn.functional.pad(x, flat)
kernel_name = 'standalone__tree_speculative_verify_tree_attention_over_candidate_token_tree__decode'

def setup_inputs():

    _w = lambda a: (lambda t: t.to(torch.bfloat16) if t.is_floating_point() else t)(torch.as_tensor(a))
    B, Hq, Hkv, T, C, D = (8, 32, 8, 1, 4096, 128)
    tree_mask = torch.zeros((B, T, T), dtype=float)
    for b in range(B):
        parent = torch.zeros(T, dtype=torch.int64)
        for i in range(1, T):
            parent[i] = int(torch.randint(0, i, (1,)).item())
        for i in range(T):
            j = i
            tree_mask[b, i, j] = 1.0
            while j > 0:
                j = parent[j]
                tree_mask[b, i, j] = 1.0
    return {'q': _w((lambda *s: torch.randn(*s, dtype=torch.bfloat16) * 0.8)(B, Hq, T, D)), 'k_cache': _w((lambda *s: torch.randn(*s, dtype=torch.bfloat16) * 0.8)(B, Hkv, C, D)), 'v_cache': _w((lambda *s: torch.randn(*s, dtype=torch.bfloat16) * 0.05)(B, Hkv, C, D)), 'k_tree': _w((lambda *s: torch.randn(*s, dtype=torch.bfloat16) * 0.8)(B, Hkv, T, D)), 'v_tree': _w((lambda *s: torch.randn(*s, dtype=torch.bfloat16) * 0.05)(B, Hkv, T, D)), 'tree_mask': _w(tree_mask)}

def reference(q, k_cache, v_cache, k_tree, v_tree, tree_mask):
    B, Hq, T, D = q.shape
    Hkv, C = (k_cache.shape[1], k_cache.shape[2])
    rep = Hq // Hkv
    kc = (lambda x, n, axis: torch.repeat_interleave(x, n, dim=axis))(k_cache, rep, axis=1)
    vc = (lambda x, n, axis: torch.repeat_interleave(x, n, dim=axis))(v_cache, rep, axis=1)
    kt = (lambda x, n, axis: torch.repeat_interleave(x, n, dim=axis))(k_tree, rep, axis=1)
    vt = (lambda x, n, axis: torch.repeat_interleave(x, n, dim=axis))(v_tree, rep, axis=1)
    k = torch.concatenate([kc, kt], axis=2)
    v = torch.concatenate([vc, vt], axis=2)
    scale = D ** (-0.5)
    scores = torch.einsum('bhqd,bhkd->bhqk', q, k) * scale
    ctx_mask = torch.ones((B, 1, T, C), dtype=scores.dtype)
    tm = tree_mask[:, None, :, :].clone()
    full_mask = torch.concatenate([ctx_mask, tm], axis=-1)
    scores = scores + (1.0 - full_mask) * -1000000000.0
    p = _softmax(scores, axis=-1)
    return torch.einsum('bhqk,bhkd->bhqd', p, v)
```

```asm
; @launch grid=(256,1,1) block=(256,1,1) lds=144128
.amdgcn_target "amdgcn-amd-amdhsa--gfx950"
.text
.globl standalone__tree_speculative_verify_tree_attention_over_candidate_token_tree__decode_kernel
.p2align 8
.type standalone__tree_speculative_verify_tree_attention_over_candidate_token_tree__decode_kernel,@function
standalone__tree_speculative_verify_tree_attention_over_candidate_token_tree__decode_kernel:
    s_load_dwordx16 s[4:19], s[0:1], 0
    s_load_dwordx2 s[20:21], s[0:1], 64
    s_cmp_ge_u32 s2, 256
    s_cbranch_scc1 L_end
    v_readfirstlane_b32 s3, v0
    v_and_b32 v1, 63, v0
    v_lshlrev_b32 v2, 4, v1
    s_mov_b32 s26, 0x4000000
    s_mov_b32 s27, 0x20000
    s_lshr_b32 s3, s3, 6
    s_and_b32 s38, s2, 7
    s_bfe_u32 s37, s2, 0x20003
    s_lshr_b32 s39, s2, 5
    s_lshl_b32 s36, s38, 3
    s_add_u32 s36, s36, s39
    s_lshl_b32 s38, s37, 18
    s_lshl_b32 s39, s3, 10
    v_add_u32 v3, s39, v2
    s_movk_i32 s97, 0x1000
    s_lshl_b32 s32, s36, 20
    s_add_u32 s32, s32, s38
    s_mul_i32 s34, s3, 33792
    s_movk_i32 s42, 1056
    s_mov_b32 m0, s34
    v_and_b32 v6, 3, v1
    v_lshlrev_b32 v6, 8, v6
    v_lshrrev_b32 v7, 4, v1
    v_lshlrev_b32 v7, 4, v7
    s_lshl_b32 s38, s36, 10
    v_add3_u32 v6, v6, v7, s38
    s_waitcnt lgkmcnt(0)
    s_mov_b64 s[24:25], s[6:7]
    global_load_dwordx4 v[16:19], v6, s[4:5] offset:0
    global_load_dwordx4 v[20:23], v6, s[4:5] offset:64
    global_load_dwordx4 v[24:27], v6, s[4:5] offset:128
    global_load_dwordx4 v[28:31], v6, s[4:5] offset:192
    s_lshl_b32 s40, s36, 7
    s_add_u32 s40, s40, 1048576
    s_load_dword s98, s[20:21], s40
    s_mov_b32 s33, s32
    buffer_load_dwordx4 v3, s[24:27], s33 offen nt lds
    s_add_u32 m0, m0, s42
    s_add_u32 s33, s33, s97
    buffer_load_dwordx4 v3, s[24:27], s33 offen nt lds
    s_add_u32 m0, m0, s42
    s_add_u32 s33, s33, s97
    buffer_load_dwordx4 v3, s[24:27], s33 offen nt lds
    s_add_u32 m0, m0, s42
    s_add_u32 s33, s33, s97
    buffer_load_dwordx4 v3, s[24:27], s33 offen nt lds
    s_add_u32 m0, m0, s42
    s_add_u32 s33, s33, s97
    buffer_load_dwordx4 v3, s[24:27], s33 offen nt lds
    s_add_u32 m0, m0, s42
    s_add_u32 s33, s33, s97
    buffer_load_dwordx4 v3, s[24:27], s33 offen nt lds
    s_add_u32 m0, m0, s42
    s_add_u32 s33, s33, s97
    buffer_load_dwordx4 v3, s[24:27], s33 offen nt lds
    s_add_u32 m0, m0, s42
    s_add_u32 s33, s33, s97
    buffer_load_dwordx4 v3, s[24:27], s33 offen nt lds
    s_mov_b64 s[28:29], s[8:9]
    s_mov_b64 s[30:31], s[26:27]
    s_lshl_b32 s2, s36, 2
    s_add_u32 s2, s2, s37
    s_getreg_b32 s43, hwreg(HW_REG_XCC_ID, 0, 4)
    s_mov_b32 s23, 4000000
    v_lshrrev_b32 v7, 4, v1
    v_lshlrev_b32 v7, 4, v7
    s_lshl_b32 s39, s36, 8
    v_add_u32 v7, s39, v7
    v_lshlrev_b32 v8, 2, v1
    v_add_u32 v8, s39, v8
    s_lshr_b32 s40, s36, 3
    s_lshl_b32 s40, s40, 1
    v_mov_b32 v9, s40
    global_load_dwordx4 v[192:195], v7, s[10:11] offset:0
    global_load_dwordx4 v[196:199], v7, s[10:11] offset:64
    global_load_dwordx4 v[200:203], v7, s[10:11] offset:128
    global_load_dwordx4 v[204:207], v7, s[10:11] offset:192
    global_load_dword v11, v8, s[12:13]
    global_load_ushort v12, v9, s[14:15]
    s_barrier
    s_add_u32 m0, s34, 8448
    s_xor_b32 s33, s32, 32768
    buffer_load_dwordx4 v3, s[24:27], s33 offen nt lds
    s_add_u32 m0, s34, 9504
    s_add_u32 s33, s33, s97
    buffer_load_dwordx4 v3, s[24:27], s33 offen nt lds
    s_add_u32 m0, s34, 10560
    s_add_u32 s33, s33, s97
    buffer_load_dwordx4 v3, s[24:27], s33 offen nt lds
    s_add_u32 m0, s34, 11616
    s_add_u32 s33, s33, s97
    buffer_load_dwordx4 v3, s[24:27], s33 offen nt lds
    s_add_u32 m0, s34, 12672
    s_add_u32 s33, s33, s97
    buffer_load_dwordx4 v3, s[24:27], s33 offen nt lds
    s_add_u32 m0, s34, 13728
    s_add_u32 s33, s33, s97
    buffer_load_dwordx4 v3, s[24:27], s33 offen nt lds
    s_add_u32 m0, s34, 14784
    s_add_u32 s33, s33, s97
    buffer_load_dwordx4 v3, s[24:27], s33 offen nt lds
    s_add_u32 m0, s34, 15840
    s_add_u32 s33, s33, s97
    buffer_load_dwordx4 v3, s[24:27], s33 offen nt lds
    s_barrier
    s_add_u32 m0, s34, 16896
    s_xor_b32 s33, s32, 65536
    buffer_load_dwordx4 v3, s[24:27], s33 offen nt lds
    s_add_u32 m0, s34, 17952
    s_add_u32 s33, s33, s97
    buffer_load_dwordx4 v3, s[24:27], s33 offen nt lds
    s_add_u32 m0, s34, 19008
    s_add_u32 s33, s33, s97
    buffer_load_dwordx4 v3, s[24:27], s33 offen nt lds
    s_add_u32 m0, s34, 20064
    s_add_u32 s33, s33, s97
    buffer_load_dwordx4 v3, s[24:27], s33 offen nt lds
    s_add_u32 m0, s34, 21120
    s_add_u32 s33, s33, s97
    buffer_load_dwordx4 v3, s[24:27], s33 offen nt lds
    s_add_u32 m0, s34, 22176
    s_add_u32 s33, s33, s97
    buffer_load_dwordx4 v3, s[24:27], s33 offen nt lds
    s_add_u32 m0, s34, 23232
    s_add_u32 s33, s33, s97
    buffer_load_dwordx4 v3, s[24:27], s33 offen nt lds
    s_add_u32 m0, s34, 24288
    s_add_u32 s33, s33, s97
    buffer_load_dwordx4 v3, s[24:27], s33 offen nt lds
    s_barrier
    s_add_u32 m0, s34, 25344
    s_xor_b32 s33, s32, 98304
    buffer_load_dwordx4 v3, s[24:27], s33 offen nt lds
    s_add_u32 m0, s34, 26400
    s_add_u32 s33, s33, s97
    buffer_load_dwordx4 v3, s[24:27], s33 offen nt lds
    s_add_u32 m0, s34, 27456
    s_add_u32 s33, s33, s97
    buffer_load_dwordx4 v3, s[24:27], s33 offen nt lds
    s_add_u32 m0, s34, 28512
    s_add_u32 s33, s33, s97
    buffer_load_dwordx4 v3, s[24:27], s33 offen nt lds
    s_add_u32 m0, s34, 29568
    s_add_u32 s33, s33, s97
    buffer_load_dwordx4 v3, s[24:27], s33 offen nt lds
    s_add_u32 m0, s34, 30624
    s_add_u32 s33, s33, s97
    buffer_load_dwordx4 v3, s[24:27], s33 offen nt lds
    s_add_u32 m0, s34, 31680
    s_add_u32 s33, s33, s97
    buffer_load_dwordx4 v3, s[24:27], s33 offen nt lds
    s_add_u32 m0, s34, 32736
    s_add_u32 s33, s33, s97
    buffer_load_dwordx4 v3, s[24:27], s33 offen nt lds
    v_and_b32 v6, 7, v1
    v_mul_u32_u24 v6, 1056, v6
    v_bfe_u32 v7, v1, 3, 1
    v_lshlrev_b32 v7, 8, v7
    v_lshrrev_b32 v8, 4, v1
    v_lshlrev_b32 v8, 4, v8
    v_add3_u32 v4, v6, v7, v8
    v_add_u32 v4, s34, v4
    v_bfe_u32 v6, v1, 2, 3
    v_mul_u32_u24 v6, 1056, v6
    v_lshrrev_b32 v7, 5, v1
    v_lshlrev_b32 v7, 8, v7
    v_and_b32 v8, 3, v1
    v_lshlrev_b32 v8, 3, v8
    v_add3_u32 v5, v6, v7, v8
    v_add_u32 v5, s34, v5
    s_mov_b32 s35, 0x3e0293ee
    v_mov_b32 v160, 0
    v_mov_b32 v161, 0
    v_mov_b32 v162, 0
    v_mov_b32 v163, 0
    v_mov_b32 v164, 0
    v_mov_b32 v165, 0
    v_mov_b32 v166, 0
    v_mov_b32 v167, 0
    s_mov_b32 s88, 0xf000f
    s_mov_b32 s89, s88
    s_mov_b32 s90, 0xf000f0
    s_mov_b32 s91, s90
    s_mov_b32 s92, 0xf000f00
    s_mov_b32 s93, s92
    s_mov_b32 s94, 0xf000f000
    s_mov_b32 s95, s94
    s_waitcnt vmcnt(24)
    ds_read_b128 v[32:35], v4 offset:0
    ds_read_b128 v[36:39], v4 offset:64
    ds_read_b128 v[40:43], v4 offset:128
    ds_read_b128 v[44:47], v4 offset:192
    ds_read_b128 v[48:51], v4 offset:512
    ds_read_b128 v[52:55], v4 offset:576
    ds_read_b128 v[56:59], v4 offset:640
    ds_read_b128 v[60:63], v4 offset:704
    s_waitcnt lgkmcnt(0)
    s_mul_i32 s99, s98, 1664525
    s_add_u32 s99, s99, 1013904223
    s_cmp_eq_u32 s3, s37
    s_cbranch_scc0 L_noxcc
    s_or_b32 s39, s43, 0x80
    s_xor_b32 s39, s39, s99
    s_lshl_b32 s38, s36, 7
    s_lshl_b32 s40, s37, 3
    s_add_u32 s38, s38, s40
    s_add_u32 s38, s38, 1114112
    v_mov_b32 v6, s38
    v_mov_b32 v8, s99
    v_mov_b32 v9, s39
    s_mov_b64 exec, 1
    global_store_dwordx2 v6, v[8:9], s[20:21] sc1
    s_mov_b64 exec, -1
L_noxcc:
    s_barrier
    s_add_u32 m0, s34, 0
    s_xor_b32 s33, s32, 131072
    buffer_load_dwordx4 v3, s[24:27], s33 offen nt lds
    s_add_u32 m0, s34, 1056
    s_add_u32 s33, s33, s97
    buffer_load_dwordx4 v3, s[24:27], s33 offen nt lds
    s_add_u32 m0, s34, 2112
    s_add_u32 s33, s33, s97
    buffer_load_dwordx4 v3, s[24:27], s33 offen nt lds
    s_add_u32 m0, s34, 3168
    s_add_u32 s33, s33, s97
    buffer_load_dwordx4 v3, s[24:27], s33 offen nt lds
    s_add_u32 m0, s34, 4224
    s_add_u32 s33, s33, s97
    buffer_load_dwordx4 v3, s[24:27], s33 offen nt lds
    s_add_u32 m0, s34, 5280
    s_add_u32 s33, s33, s97
    buffer_load_dwordx4 v3, s[24:27], s33 offen nt lds
    s_add_u32 m0, s34, 6336
    s_add_u32 s33, s33, s97
    buffer_load_dwordx4 v3, s[24:27], s33 offen nt lds
    s_add_u32 m0, s34, 7392
    s_add_u32 s33, s33, s97
    buffer_load_dwordx4 v3, s[24:27], s33 offen nt lds
    v_mfma_f32_16x16x32_bf16 v[64:67], v[32:35], v[16:19], 0
    v_mfma_f32_16x16x32_bf16 v[68:71], v[48:51], v[16:19], 0
    v_mfma_f32_16x16x32_bf16 v[64:67], v[36:39], v[20:23], v[64:67]
    v_mfma_f32_16x16x32_bf16 v[68:71], v[52:55], v[20:23], v[68:71]
    v_mfma_f32_16x16x32_bf16 v[64:67], v[40:43], v[24:27], v[64:67]
    v_mfma_f32_16x16x32_bf16 v[68:71], v[56:59], v[24:27], v[68:71]
    v_mfma_f32_16x16x32_bf16 v[64:67], v[44:47], v[28:31], v[64:67]
    v_mfma_f32_16x16x32_bf16 v[68:71], v[60:63], v[28:31], v[68:71]
    v_mfma_f32_16x16x32_bf16 v[208:211], v[192:195], v[16:19], 0
    v_mfma_f32_16x16x32_bf16 v[208:211], v[196:199], v[20:23], v[208:211]
    v_mfma_f32_16x16x32_bf16 v[208:211], v[200:203], v[24:27], v[208:211]
    v_mfma_f32_16x16x32_bf16 v[208:211], v[204:207], v[28:31], v[208:211]
    v_lshlrev_b32 v12, 16, v12
    v_sub_f32 v12, 1.0, v12
    v_mul_f32 v12, 0xceabfb8f, v12
    s_cmp_eq_u32 s37, 0
    s_cselect_b32 s39, 0, 0xff800000
    s_nop 2
    v_readlane_b32 s40, v208, s3
    s_nop 1
    v_mov_b32 v10, s40
    v_fma_f32 v10, v10, s35, v12
    v_add_f32 v10, s39, v10
    s_waitcnt vmcnt(24)
    ds_read_b128 v[32:35], v4 offset:8448
    ds_read_b128 v[36:39], v4 offset:8512
    ds_read_b128 v[40:43], v4 offset:8576
    ds_read_b128 v[44:47], v4 offset:8640
    ds_read_b128 v[48:51], v4 offset:8960
    ds_read_b128 v[52:55], v4 offset:9024
    ds_read_b128 v[56:59], v4 offset:9088
    ds_read_b128 v[60:63], v4 offset:9152
    s_waitcnt lgkmcnt(0)
    s_barrier
    s_add_u32 m0, s34, 8448
    s_xor_b32 s33, s32, 163840
    buffer_load_dwordx4 v3, s[24:27], s33 offen nt lds
    s_add_u32 m0, s34, 9504
    s_add_u32 s33, s33, s97
    buffer_load_dwordx4 v3, s[24:27], s33 offen nt lds
    s_add_u32 m0, s34, 10560
    s_add_u32 s33, s33, s97
    buffer_load_dwordx4 v3, s[24:27], s33 offen nt lds
    s_add_u32 m0, s34, 11616
    s_add_u32 s33, s33, s97
    buffer_load_dwordx4 v3, s[24:27], s33 offen nt lds
    s_add_u32 m0, s34, 12672
    s_add_u32 s33, s33, s97
    buffer_load_dwordx4 v3, s[24:27], s33 offen nt lds
    s_add_u32 m0, s34, 13728
    s_add_u32 s33, s33, s97
    buffer_load_dwordx4 v3, s[24:27], s33 offen nt lds
    s_add_u32 m0, s34, 14784
    s_add_u32 s33, s33, s97
    buffer_load_dwordx4 v3, s[24:27], s33 offen nt lds
    s_add_u32 m0, s34, 15840
    s_add_u32 s33, s33, s97
    buffer_load_dwordx4 v3, s[24:27], s33 offen nt lds
    v_mfma_f32_16x16x32_bf16 v[72:75], v[32:35], v[16:19], 0
    v_mfma_f32_16x16x32_bf16 v[76:79], v[48:51], v[16:19], 0
    v_mfma_f32_16x16x32_bf16 v[72:75], v[36:39], v[20:23], v[72:75]
    v_mfma_f32_16x16x32_bf16 v[76:79], v[52:55], v[20:23], v[76:79]
    v_mfma_f32_16x16x32_bf16 v[72:75], v[40:43], v[24:27], v[72:75]
    v_mfma_f32_16x16x32_bf16 v[76:79], v[56:59], v[24:27], v[76:79]
    v_mfma_f32_16x16x32_bf16 v[72:75], v[44:47], v[28:31], v[72:75]
    v_mfma_f32_16x16x32_bf16 v[76:79], v[60:63], v[28:31], v[76:79]
    s_waitcnt vmcnt(24)
    ds_read_b128 v[32:35], v4 offset:16896
    ds_read_b128 v[36:39], v4 offset:16960
    ds_read_b128 v[40:43], v4 offset:17024
    ds_read_b128 v[44:47], v4 offset:17088
    ds_read_b128 v[48:51], v4 offset:17408
    ds_read_b128 v[52:55], v4 offset:17472
    ds_read_b128 v[56:59], v4 offset:17536
    ds_read_b128 v[60:63], v4 offset:17600
    s_waitcnt lgkmcnt(0)
    s_barrier
    s_add_u32 m0, s34, 16896
    s_xor_b32 s33, s32, 196608
    buffer_load_dwordx4 v3, s[24:27], s33 offen nt lds
    s_add_u32 m0, s34, 17952
    s_add_u32 s33, s33, s97
    buffer_load_dwordx4 v3, s[24:27], s33 offen nt lds
    s_add_u32 m0, s34, 19008
    s_add_u32 s33, s33, s97
    buffer_load_dwordx4 v3, s[24:27], s33 offen nt lds
    s_add_u32 m0, s34, 20064
    s_add_u32 s33, s33, s97
    buffer_load_dwordx4 v3, s[24:27], s33 offen nt lds
    s_add_u32 m0, s34, 21120
    s_add_u32 s33, s33, s97
    buffer_load_dwordx4 v3, s[24:27], s33 offen nt lds
    s_add_u32 m0, s34, 22176
    s_add_u32 s33, s33, s97
    buffer_load_dwordx4 v3, s[24:27], s33 offen nt lds
    s_add_u32 m0, s34, 23232
    s_add_u32 s33, s33, s97
    buffer_load_dwordx4 v3, s[24:27], s33 offen nt lds
    s_add_u32 m0, s34, 24288
    s_add_u32 s33, s33, s97
    buffer_load_dwordx4 v3, s[24:27], s33 offen nt lds
    v_mfma_f32_16x16x32_bf16 v[80:83], v[32:35], v[16:19], 0
    v_mfma_f32_16x16x32_bf16 v[84:87], v[48:51], v[16:19], 0
    v_mfma_f32_16x16x32_bf16 v[80:83], v[36:39], v[20:23], v[80:83]
    v_mfma_f32_16x16x32_bf16 v[84:87], v[52:55], v[20:23], v[84:87]
    v_mfma_f32_16x16x32_bf16 v[80:83], v[40:43], v[24:27], v[80:83]
    v_mfma_f32_16x16x32_bf16 v[84:87], v[56:59], v[24:27], v[84:87]
    v_mfma_f32_16x16x32_bf16 v[80:83], v[44:47], v[28:31], v[80:83]
    v_mfma_f32_16x16x32_bf16 v[84:87], v[60:63], v[28:31], v[84:87]
    s_waitcnt vmcnt(24)
    ds_read_b128 v[32:35], v4 offset:25344
    ds_read_b128 v[36:39], v4 offset:25408
    ds_read_b128 v[40:43], v4 offset:25472
    ds_read_b128 v[44:47], v4 offset:25536
    ds_read_b128 v[48:51], v4 offset:25856
    ds_read_b128 v[52:55], v4 offset:25920
    ds_read_b128 v[56:59], v4 offset:25984
    ds_read_b128 v[60:63], v4 offset:26048
    s_waitcnt lgkmcnt(0)
    s_barrier
    s_add_u32 m0, s34, 25344
    s_xor_b32 s33, s32, 229376
    buffer_load_dwordx4 v3, s[24:27], s33 offen nt lds
    s_add_u32 m0, s34, 26400
    s_add_u32 s33, s33, s97
    buffer_load_dwordx4 v3, s[24:27], s33 offen nt lds
    s_add_u32 m0, s34, 27456
    s_add_u32 s33, s33, s97
    buffer_load_dwordx4 v3, s[24:27], s33 offen nt lds
    s_add_u32 m0, s34, 28512
    s_add_u32 s33, s33, s97
    buffer_load_dwordx4 v3, s[24:27], s33 offen nt lds
    s_add_u32 m0, s34, 29568
    s_add_u32 s33, s33, s97
    buffer_load_dwordx4 v3, s[24:27], s33 offen nt lds
    s_add_u32 m0, s34, 30624
    s_add_u32 s33, s33, s97
    buffer_load_dwordx4 v3, s[24:27], s33 offen nt lds
    s_add_u32 m0, s34, 31680
    s_add_u32 s33, s33, s97
    buffer_load_dwordx4 v3, s[24:27], s33 offen nt lds
    s_add_u32 m0, s34, 32736
    s_add_u32 s33, s33, s97
    buffer_load_dwordx4 v3, s[24:27], s33 offen nt lds
    v_mfma_f32_16x16x32_bf16 v[88:91], v[32:35], v[16:19], 0
    v_mfma_f32_16x16x32_bf16 v[92:95], v[48:51], v[16:19], 0
    v_mfma_f32_16x16x32_bf16 v[88:91], v[36:39], v[20:23], v[88:91]
    v_mfma_f32_16x16x32_bf16 v[92:95], v[52:55], v[20:23], v[92:95]
    v_mfma_f32_16x16x32_bf16 v[88:91], v[40:43], v[24:27], v[88:91]
    v_mfma_f32_16x16x32_bf16 v[92:95], v[56:59], v[24:27], v[92:95]
    v_mfma_f32_16x16x32_bf16 v[88:91], v[44:47], v[28:31], v[88:91]
    v_mfma_f32_16x16x32_bf16 v[92:95], v[60:63], v[28:31], v[92:95]
    s_waitcnt vmcnt(24)
    ds_read_b128 v[32:35], v4 offset:0
    ds_read_b128 v[36:39], v4 offset:64
    ds_read_b128 v[40:43], v4 offset:128
    ds_read_b128 v[44:47], v4 offset:192
    ds_read_b128 v[48:51], v4 offset:512
    ds_read_b128 v[52:55], v4 offset:576
    ds_read_b128 v[56:59], v4 offset:640
    ds_read_b128 v[60:63], v4 offset:704
    s_waitcnt lgkmcnt(0)
    s_barrier
    s_add_u32 m0, s34, 0
    s_mov_b32 s33, s32
    buffer_load_dwordx4 v3, s[28:31], s33 offen nt lds
    s_add_u32 m0, s34, 1056
    s_add_u32 s33, s33, s97
    buffer_load_dwordx4 v3, s[28:31], s33 offen nt lds
    s_add_u32 m0, s34, 2112
    s_add_u32 s33, s33, s97
    buffer_load_dwordx4 v3, s[28:31], s33 offen nt lds
    s_add_u32 m0, s34, 3168
    s_add_u32 s33, s33, s97
    buffer_load_dwordx4 v3, s[28:31], s33 offen nt lds
    s_add_u32 m0, s34, 4224
    s_add_u32 s33, s33, s97
    buffer_load_dwordx4 v3, s[28:31], s33 offen nt lds
    s_add_u32 m0, s34, 5280
    s_add_u32 s33, s33, s97
    buffer_load_dwordx4 v3, s[28:31], s33 offen nt lds
    s_add_u32 m0, s34, 6336
    s_add_u32 s33, s33, s97
    buffer_load_dwordx4 v3, s[28:31], s33 offen nt lds
    s_add_u32 m0, s34, 7392
    s_add_u32 s33, s33, s97
    buffer_load_dwordx4 v3, s[28:31], s33 offen nt lds
    v_mfma_f32_16x16x32_bf16 v[96:99], v[32:35], v[16:19], 0
    v_mfma_f32_16x16x32_bf16 v[100:103], v[48:51], v[16:19], 0
    v_mfma_f32_16x16x32_bf16 v[96:99], v[36:39], v[20:23], v[96:99]
    v_mfma_f32_16x16x32_bf16 v[100:103], v[52:55], v[20:23], v[100:103]
    v_mfma_f32_16x16x32_bf16 v[96:99], v[40:43], v[24:27], v[96:99]
    v_mfma_f32_16x16x32_bf16 v[100:103], v[56:59], v[24:27], v[100:103]
    v_mfma_f32_16x16x32_bf16 v[96:99], v[44:47], v[28:31], v[96:99]
    v_mfma_f32_16x16x32_bf16 v[100:103], v[60:63], v[28:31], v[100:103]
    s_waitcnt vmcnt(24)
    ds_read_b128 v[32:35], v4 offset:8448
    ds_read_b128 v[36:39], v4 offset:8512
    ds_read_b128 v[40:43], v4 offset:8576
    ds_read_b128 v[44:47], v4 offset:8640
    ds_read_b128 v[48:51], v4 offset:8960
    ds_read_b128 v[52:55], v4 offset:9024
    ds_read_b128 v[56:59], v4 offset:9088
    ds_read_b128 v[60:63], v4 offset:9152
    s_waitcnt lgkmcnt(0)
    s_barrier
    s_add_u32 m0, s34, 8448
    s_xor_b32 s33, s32, 32768
    buffer_load_dwordx4 v3, s[28:31], s33 offen nt lds
    s_add_u32 m0, s34, 9504
    s_add_u32 s33, s33, s97
    buffer_load_dwordx4 v3, s[28:31], s33 offen nt lds
    s_add_u32 m0, s34, 10560
    s_add_u32 s33, s33, s97
    buffer_load_dwordx4 v3, s[28:31], s33 offen nt lds
    s_add_u32 m0, s34, 11616
    s_add_u32 s33, s33, s97
    buffer_load_dwordx4 v3, s[28:31], s33 offen nt lds
    s_add_u32 m0, s34, 12672
    s_add_u32 s33, s33, s97
    buffer_load_dwordx4 v3, s[28:31], s33 offen nt lds
    s_add_u32 m0, s34, 13728
    s_add_u32 s33, s33, s97
    buffer_load_dwordx4 v3, s[28:31], s33 offen nt lds
    s_add_u32 m0, s34, 14784
    s_add_u32 s33, s33, s97
    buffer_load_dwordx4 v3, s[28:31], s33 offen nt lds
    s_add_u32 m0, s34, 15840
    s_add_u32 s33, s33, s97
    buffer_load_dwordx4 v3, s[28:31], s33 offen nt lds
    v_mfma_f32_16x16x32_bf16 v[104:107], v[32:35], v[16:19], 0
    v_mfma_f32_16x16x32_bf16 v[108:111], v[48:51], v[16:19], 0
    v_mfma_f32_16x16x32_bf16 v[104:107], v[36:39], v[20:23], v[104:107]
    v_mfma_f32_16x16x32_bf16 v[108:111], v[52:55], v[20:23], v[108:111]
    v_mfma_f32_16x16x32_bf16 v[104:107], v[40:43], v[24:27], v[104:107]
    v_mfma_f32_16x16x32_bf16 v[108:111], v[56:59], v[24:27], v[108:111]
    v_mfma_f32_16x16x32_bf16 v[104:107], v[44:47], v[28:31], v[104:107]
    v_mfma_f32_16x16x32_bf16 v[108:111], v[60:63], v[28:31], v[108:111]
    s_waitcnt vmcnt(24)
    ds_read_b128 v[32:35], v4 offset:16896
    ds_read_b128 v[36:39], v4 offset:16960
    ds_read_b128 v[40:43], v4 offset:17024
    ds_read_b128 v[44:47], v4 offset:17088
    ds_read_b128 v[48:51], v4 offset:17408
    ds_read_b128 v[52:55], v4 offset:17472
    ds_read_b128 v[56:59], v4 offset:17536
    ds_read_b128 v[60:63], v4 offset:17600
    s_waitcnt lgkmcnt(0)
    s_barrier
    s_add_u32 m0, s34, 16896
    s_xor_b32 s33, s32, 65536
    buffer_load_dwordx4 v3, s[28:31], s33 offen nt lds
    s_add_u32 m0, s34, 17952
    s_add_u32 s33, s33, s97
    buffer_load_dwordx4 v3, s[28:31], s33 offen nt lds
    s_add_u32 m0, s34, 19008
    s_add_u32 s33, s33, s97
    buffer_load_dwordx4 v3, s[28:31], s33 offen nt lds
    s_add_u32 m0, s34, 20064
    s_add_u32 s33, s33, s97
    buffer_load_dwordx4 v3, s[28:31], s33 offen nt lds
    s_add_u32 m0, s34, 21120
    s_add_u32 s33, s33, s97
    buffer_load_dwordx4 v3, s[28:31], s33 offen nt lds
    s_add_u32 m0, s34, 22176
    s_add_u32 s33, s33, s97
    buffer_load_dwordx4 v3, s[28:31], s33 offen nt lds
    s_add_u32 m0, s34, 23232
    s_add_u32 s33, s33, s97
    buffer_load_dwordx4 v3, s[28:31], s33 offen nt lds
    s_add_u32 m0, s34, 24288
    s_add_u32 s33, s33, s97
    buffer_load_dwordx4 v3, s[28:31], s33 offen nt lds
    v_mfma_f32_16x16x32_bf16 v[112:115], v[32:35], v[16:19], 0
    v_mfma_f32_16x16x32_bf16 v[116:119], v[48:51], v[16:19], 0
    v_mfma_f32_16x16x32_bf16 v[112:115], v[36:39], v[20:23], v[112:115]
    v_mfma_f32_16x16x32_bf16 v[116:119], v[52:55], v[20:23], v[116:119]
    v_mfma_f32_16x16x32_bf16 v[112:115], v[40:43], v[24:27], v[112:115]
    v_mfma_f32_16x16x32_bf16 v[116:119], v[56:59], v[24:27], v[116:119]
    v_mfma_f32_16x16x32_bf16 v[112:115], v[44:47], v[28:31], v[112:115]
    v_mfma_f32_16x16x32_bf16 v[116:119], v[60:63], v[28:31], v[116:119]
    s_waitcnt vmcnt(24)
    ds_read_b128 v[32:35], v4 offset:25344
    ds_read_b128 v[36:39], v4 offset:25408
    ds_read_b128 v[40:43], v4 offset:25472
    ds_read_b128 v[44:47], v4 offset:25536
    ds_read_b128 v[48:51], v4 offset:25856
    ds_read_b128 v[52:55], v4 offset:25920
    ds_read_b128 v[56:59], v4 offset:25984
    ds_read_b128 v[60:63], v4 offset:26048
    s_waitcnt lgkmcnt(0)
    s_barrier
    s_add_u32 m0, s34, 25344
    s_xor_b32 s33, s32, 98304
    buffer_load_dwordx4 v3, s[28:31], s33 offen nt lds
    s_add_u32 m0, s34, 26400
    s_add_u32 s33, s33, s97
    buffer_load_dwordx4 v3, s[28:31], s33 offen nt lds
    s_add_u32 m0, s34, 27456
    s_add_u32 s33, s33, s97
    buffer_load_dwordx4 v3, s[28:31], s33 offen nt lds
    s_add_u32 m0, s34, 28512
    s_add_u32 s33, s33, s97
    buffer_load_dwordx4 v3, s[28:31], s33 offen nt lds
    s_add_u32 m0, s34, 29568
    s_add_u32 s33, s33, s97
    buffer_load_dwordx4 v3, s[28:31], s33 offen nt lds
    s_add_u32 m0, s34, 30624
    s_add_u32 s33, s33, s97
    buffer_load_dwordx4 v3, s[28:31], s33 offen nt lds
    s_add_u32 m0, s34, 31680
    s_add_u32 s33, s33, s97
    buffer_load_dwordx4 v3, s[28:31], s33 offen nt lds
    s_add_u32 m0, s34, 32736
    s_add_u32 s33, s33, s97
    buffer_load_dwordx4 v3, s[28:31], s33 offen nt lds
    v_mfma_f32_16x16x32_bf16 v[120:123], v[32:35], v[16:19], 0
    v_mfma_f32_16x16x32_bf16 v[124:127], v[48:51], v[16:19], 0
    v_mfma_f32_16x16x32_bf16 v[120:123], v[36:39], v[20:23], v[120:123]
    v_mfma_f32_16x16x32_bf16 v[124:127], v[52:55], v[20:23], v[124:127]
    v_mfma_f32_16x16x32_bf16 v[120:123], v[40:43], v[24:27], v[120:123]
    v_mfma_f32_16x16x32_bf16 v[124:127], v[56:59], v[24:27], v[124:127]
    v_mfma_f32_16x16x32_bf16 v[120:123], v[44:47], v[28:31], v[120:123]
    v_mfma_f32_16x16x32_bf16 v[124:127], v[60:63], v[28:31], v[124:127]
    v_max3_f32 v13, v64, v65, v66
    v_max3_f32 v7, v67, v68, v69
    v_max3_f32 v8, v70, v71, v72
    v_max3_f32 v9, v73, v74, v75
    v_max3_f32 v13, v13, v76, v77
    v_max3_f32 v7, v7, v78, v79
    v_max3_f32 v8, v8, v80, v81
    v_max3_f32 v9, v9, v82, v83
    v_max3_f32 v13, v13, v84, v85
    v_max3_f32 v7, v7, v86, v87
    v_max3_f32 v8, v8, v88, v89
    v_max3_f32 v9, v9, v90, v91
    v_max3_f32 v13, v13, v92, v93
    v_max3_f32 v7, v7, v94, v95
    v_max3_f32 v8, v8, v96, v97
    v_max3_f32 v9, v9, v98, v99
    v_max3_f32 v13, v13, v100, v101
    v_max3_f32 v7, v7, v102, v103
    v_max3_f32 v8, v8, v104, v105
    v_max3_f32 v9, v9, v106, v107
    v_max3_f32 v13, v13, v108, v109
    v_max3_f32 v7, v7, v110, v111
    v_max3_f32 v8, v8, v112, v113
    v_max3_f32 v9, v9, v114, v115
    v_max3_f32 v13, v13, v116, v117
    v_max3_f32 v7, v7, v118, v119
    v_max3_f32 v8, v8, v120, v121
    v_max3_f32 v9, v9, v122, v123
    v_max3_f32 v13, v13, v124, v125
    v_max3_f32 v7, v7, v126, v127
    v_max3_f32 v13, v13, v7, v8
    v_max_f32 v13, v13, v9
    v_mov_b32 v6, v13
    s_nop 1
    v_permlane32_swap_b32 v6, v13
    v_max_f32 v13, v13, v6
    v_mov_b32 v6, v13
    s_nop 1
    v_permlane16_swap_b32 v6, v13
    v_max_f32 v13, v13, v6
    v_mul_f32 v13, s35, v13
    v_mov_b32 v14, 0
    v_mov_b32 v12, 0
    v_fma_f32 v64, v64, s35, -v13
    v_fma_f32 v65, v65, s35, -v13
    v_fma_f32 v66, v66, s35, -v13
    v_fma_f32 v67, v67, s35, -v13
    v_fma_f32 v68, v68, s35, -v13
    v_fma_f32 v69, v69, s35, -v13
    v_fma_f32 v70, v70, s35, -v13
    v_fma_f32 v71, v71, s35, -v13
    v_exp_f32 v64, v64
    v_exp_f32 v65, v65
    v_exp_f32 v66, v66
    v_exp_f32 v67, v67
    v_exp_f32 v68, v68
    v_exp_f32 v69, v69
    v_exp_f32 v70, v70
    v_exp_f32 v71, v71
    v_cvt_pk_bf16_f32 v128, v64, v65
    v_cvt_pk_bf16_f32 v129, v66, v67
    v_cvt_pk_bf16_f32 v130, v68, v69
    v_cvt_pk_bf16_f32 v131, v70, v71
    v_add_f32 v14, v14, v64
    v_add_f32 v12, v12, v65
    v_add_f32 v14, v14, v66
    v_add_f32 v12, v12, v67
    v_add_f32 v14, v14, v68
    v_add_f32 v12, v12, v69
    v_add_f32 v14, v14, v70
    v_add_f32 v12, v12, v71
    v_cndmask_b32 v168, 0, v128, s[88:89]
    v_cndmask_b32 v169, 0, v129, s[88:89]
    v_cndmask_b32 v170, 0, v130, s[88:89]
    v_cndmask_b32 v171, 0, v131, s[88:89]
    v_cndmask_b32 v172, 0, v128, s[90:91]
    v_cndmask_b32 v173, 0, v129, s[90:91]
    v_cndmask_b32 v174, 0, v130, s[90:91]
    v_cndmask_b32 v175, 0, v131, s[90:91]
    v_cndmask_b32 v176, 0, v128, s[92:93]
    v_cndmask_b32 v177, 0, v129, s[92:93]
    v_cndmask_b32 v178, 0, v130, s[92:93]
    v_cndmask_b32 v179, 0, v131, s[92:93]
    v_cndmask_b32 v180, 0, v128, s[94:95]
    v_cndmask_b32 v181, 0, v129, s[94:95]
    v_cndmask_b32 v182, 0, v130, s[94:95]
    v_cndmask_b32 v183, 0, v131, s[94:95]
    s_waitcnt vmcnt(24)
    ds_read_b64_tr_b16 v[32:33], v5 offset:0
    ds_read_b64_tr_b16 v[34:35], v5 offset:512
    ds_read_b64_tr_b16 v[36:37], v5 offset:32
    ds_read_b64_tr_b16 v[38:39], v5 offset:544
    ds_read_b64_tr_b16 v[40:41], v5 offset:64
    ds_read_b64_tr_b16 v[42:43], v5 offset:576
    ds_read_b64_tr_b16 v[44:45], v5 offset:96
    ds_read_b64_tr_b16 v[46:47], v5 offset:608
    ds_read_b64_tr_b16 v[48:49], v5 offset:128
    ds_read_b64_tr_b16 v[50:51], v5 offset:640
    ds_read_b64_tr_b16 v[52:53], v5 offset:160
    ds_read_b64_tr_b16 v[54:55], v5 offset:672
    ds_read_b64_tr_b16 v[56:57], v5 offset:192
    ds_read_b64_tr_b16 v[58:59], v5 offset:704
    ds_read_b64_tr_b16 v[60:61], v5 offset:224
    ds_read_b64_tr_b16 v[62:63], v5 offset:736
    s_waitcnt lgkmcnt(0)
    s_barrier
    s_add_u32 m0, s34, 0
    s_xor_b32 s33, s32, 131072
    buffer_load_dwordx4 v3, s[28:31], s33 offen nt lds
    s_add_u32 m0, s34, 1056
    s_add_u32 s33, s33, s97
    buffer_load_dwordx4 v3, s[28:31], s33 offen nt lds
    s_add_u32 m0, s34, 2112
    s_add_u32 s33, s33, s97
    buffer_load_dwordx4 v3, s[28:31], s33 offen nt lds
    s_add_u32 m0, s34, 3168
    s_add_u32 s33, s33, s97
    buffer_load_dwordx4 v3, s[28:31], s33 offen nt lds
    s_add_u32 m0, s34, 4224
    s_add_u32 s33, s33, s97
    buffer_load_dwordx4 v3, s[28:31], s33 offen nt lds
    s_add_u32 m0, s34, 5280
    s_add_u32 s33, s33, s97
    buffer_load_dwordx4 v3, s[28:31], s33 offen nt lds
    s_add_u32 m0, s34, 6336
    s_add_u32 s33, s33, s97
    buffer_load_dwordx4 v3, s[28:31], s33 offen nt lds
    s_add_u32 m0, s34, 7392
    s_add_u32 s33, s33, s97
    buffer_load_dwordx4 v3, s[28:31], s33 offen nt lds
    v_mfma_f32_16x16x32_bf16 v[160:163], v[32:35], v[168:171], v[160:163]
    v_mfma_f32_16x16x32_bf16 v[164:167], v[48:51], v[168:171], v[164:167]
    v_mfma_f32_16x16x32_bf16 v[160:163], v[36:39], v[172:175], v[160:163]
    v_mfma_f32_16x16x32_bf16 v[164:167], v[52:55], v[172:175], v[164:167]
    v_mfma_f32_16x16x32_bf16 v[160:163], v[40:43], v[176:179], v[160:163]
    v_mfma_f32_16x16x32_bf16 v[164:167], v[56:59], v[176:179], v[164:167]
    v_mfma_f32_16x16x32_bf16 v[160:163], v[44:47], v[180:183], v[160:163]
    v_mfma_f32_16x16x32_bf16 v[164:167], v[60:63], v[180:183], v[164:167]
    v_fma_f32 v72, v72, s35, -v13
    v_fma_f32 v73, v73, s35, -v13
    v_fma_f32 v74, v74, s35, -v13
    v_fma_f32 v75, v75, s35, -v13
    v_fma_f32 v76, v76, s35, -v13
    v_fma_f32 v77, v77, s35, -v13
    v_fma_f32 v78, v78, s35, -v13
    v_fma_f32 v79, v79, s35, -v13
    v_exp_f32 v72, v72
    v_exp_f32 v73, v73
    v_exp_f32 v74, v74
    v_exp_f32 v75, v75
    v_exp_f32 v76, v76
    v_exp_f32 v77, v77
    v_exp_f32 v78, v78
    v_exp_f32 v79, v79
    v_cvt_pk_bf16_f32 v132, v72, v73
    v_cvt_pk_bf16_f32 v133, v74, v75
    v_cvt_pk_bf16_f32 v134, v76, v77
    v_cvt_pk_bf16_f32 v135, v78, v79
    v_add_f32 v14, v14, v72
    v_add_f32 v12, v12, v73
    v_add_f32 v14, v14, v74
    v_add_f32 v12, v12, v75
    v_add_f32 v14, v14, v76
    v_add_f32 v12, v12, v77
    v_add_f32 v14, v14, v78
    v_add_f32 v12, v12, v79
    v_fma_f32 v80, v80, s35, -v13
    v_fma_f32 v81, v81, s35, -v13
    v_fma_f32 v82, v82, s35, -v13
    v_fma_f32 v83, v83, s35, -v13
    v_fma_f32 v84, v84, s35, -v13
    v_fma_f32 v85, v85, s35, -v13
    v_fma_f32 v86, v86, s35, -v13
    v_fma_f32 v87, v87, s35, -v13
    v_exp_f32 v80, v80
    v_exp_f32 v81, v81
    v_exp_f32 v82, v82
    v_exp_f32 v83, v83
    v_exp_f32 v84, v84
    v_exp_f32 v85, v85
    v_exp_f32 v86, v86
    v_exp_f32 v87, v87
    v_cvt_pk_bf16_f32 v136, v80, v81
    v_cvt_pk_bf16_f32 v137, v82, v83
    v_cvt_pk_bf16_f32 v138, v84, v85
    v_cvt_pk_bf16_f32 v139, v86, v87
    v_add_f32 v14, v14, v80
    v_add_f32 v12, v12, v81
    v_add_f32 v14, v14, v82
    v_add_f32 v12, v12, v83
    v_add_f32 v14, v14, v84
    v_add_f32 v12, v12, v85
    v_add_f32 v14, v14, v86
    v_add_f32 v12, v12, v87
    s_lshl_b32 s39, s36, 7
    s_add_u32 s39, s39, 1114112
    v_and_b32 v0, 7, v1
    v_lshlrev_b32 v0, 2, v0
    v_add_u32 v0, s39, v0
    global_load_dword v210, v0, s[20:21]
    s_or_b32 s39, s43, 0x80
    v_and_b32 v211, 1, v1
    v_mul_u32_u24 v211, s39, v211
    v_xor_b32 v211, s99, v211
    s_lshl_b32 s38, s36, 2
    s_add_u32 s38, s38, s3
    s_lshl_b32 s38, s38, 2
    s_add_u32 s38, s38, s37
    s_lshl_b32 s38, s38, 10
    v_add_u32 v195, s38, v2
    s_lshl_b32 s38, s2, 12
    s_add_u32 s39, s37, 1
    s_and_b32 s39, s39, 3
    s_lshl_b32 s39, s39, 10
    s_add_u32 s39, s39, s38
    v_add_u32 v197, s39, v2
    s_add_u32 s39, s37, 2
    s_and_b32 s39, s39, 3
    s_lshl_b32 s39, s39, 10
    s_add_u32 s39, s39, s38
    v_add_u32 v198, s39, v2
    s_add_u32 s39, s37, 3
    s_and_b32 s39, s39, 3
    s_lshl_b32 s39, s39, 10
    s_add_u32 s39, s39, s38
    v_add_u32 v199, s39, v2
    s_lshl_b32 s38, s2, 8
    v_lshlrev_b32 v196, 2, v1
    v_add_u32 v196, s38, v196
    s_mul_i32 s38, s3, 2240
    s_add_u32 s38, s38, 135168
    v_and_b32 v6, 3, v1
    v_mul_u32_u24 v7, 528, v6
    v_lshrrev_b32 v8, 4, v1
    v_lshlrev_b32 v9, 4, v8
    v_add3_u32 v192, v7, v9, s38
    v_bfe_u32 v7, v1, 2, 2
    v_lshl_add_u32 v192, v7, 6, v192
    v_lshl_add_u32 v8, v8, 2, v6
    v_lshlrev_b32 v208, 3, v8
    v_add_u32 v208, s38, v208
    s_mul_i32 s38, s3, 528
    s_add_u32 s38, s38, 135168
    v_lshlrev_b32 v193, 3, v1
    v_add_u32 v193, s38, v193
    s_lshl_b32 s39, s3, 3
    s_add_u32 s39, s39, 137280
    v_mov_b32 v194, s39
    v_cndmask_b32 v168, 0, v132, s[88:89]
    v_cndmask_b32 v169, 0, v133, s[88:89]
    v_cndmask_b32 v170, 0, v134, s[88:89]
    v_cndmask_b32 v171, 0, v135, s[88:89]
    v_cndmask_b32 v172, 0, v132, s[90:91]
    v_cndmask_b32 v173, 0, v133, s[90:91]
    v_cndmask_b32 v174, 0, v134, s[90:91]
    v_cndmask_b32 v175, 0, v135, s[90:91]
    v_cndmask_b32 v176, 0, v132, s[92:93]
    v_cndmask_b32 v177, 0, v133, s[92:93]
    v_cndmask_b32 v178, 0, v134, s[92:93]
    v_cndmask_b32 v179, 0, v135, s[92:93]
    v_cndmask_b32 v180, 0, v132, s[94:95]
    v_cndmask_b32 v181, 0, v133, s[94:95]
    v_cndmask_b32 v182, 0, v134, s[94:95]
    v_cndmask_b32 v183, 0, v135, s[94:95]
    s_waitcnt vmcnt(25)
    ds_read_b64_tr_b16 v[32:33], v5 offset:8448
    ds_read_b64_tr_b16 v[34:35], v5 offset:8960
    ds_read_b64_tr_b16 v[36:37], v5 offset:8480
    ds_read_b64_tr_b16 v[38:39], v5 offset:8992
    ds_read_b64_tr_b16 v[40:41], v5 offset:8512
    ds_read_b64_tr_b16 v[42:43], v5 offset:9024
    ds_read_b64_tr_b16 v[44:45], v5 offset:8544
    ds_read_b64_tr_b16 v[46:47], v5 offset:9056
    ds_read_b64_tr_b16 v[48:49], v5 offset:8576
    ds_read_b64_tr_b16 v[50:51], v5 offset:9088
    ds_read_b64_tr_b16 v[52:53], v5 offset:8608
    ds_read_b64_tr_b16 v[54:55], v5 offset:9120
    ds_read_b64_tr_b16 v[56:57], v5 offset:8640
    ds_read_b64_tr_b16 v[58:59], v5 offset:9152
    ds_read_b64_tr_b16 v[60:61], v5 offset:8672
    ds_read_b64_tr_b16 v[62:63], v5 offset:9184
    s_waitcnt lgkmcnt(0)
    s_barrier
    s_add_u32 m0, s34, 8448
    s_xor_b32 s33, s32, 163840
    buffer_load_dwordx4 v3, s[28:31], s33 offen nt lds
    s_add_u32 m0, s34, 9504
    s_add_u32 s33, s33, s97
    buffer_load_dwordx4 v3, s[28:31], s33 offen nt lds
    s_add_u32 m0, s34, 10560
    s_add_u32 s33, s33, s97
    buffer_load_dwordx4 v3, s[28:31], s33 offen nt lds
    s_add_u32 m0, s34, 11616
    s_add_u32 s33, s33, s97
    buffer_load_dwordx4 v3, s[28:31], s33 offen nt lds
    s_add_u32 m0, s34, 12672
    s_add_u32 s33, s33, s97
    buffer_load_dwordx4 v3, s[28:31], s33 offen nt lds
    s_add_u32 m0, s34, 13728
    s_add_u32 s33, s33, s97
    buffer_load_dwordx4 v3, s[28:31], s33 offen nt lds
    s_add_u32 m0, s34, 14784
    s_add_u32 s33, s33, s97
    buffer_load_dwordx4 v3, s[28:31], s33 offen nt lds
    s_add_u32 m0, s34, 15840
    s_add_u32 s33, s33, s97
    buffer_load_dwordx4 v3, s[28:31], s33 offen nt lds
    v_mfma_f32_16x16x32_bf16 v[160:163], v[32:35], v[168:171], v[160:163]
    v_mfma_f32_16x16x32_bf16 v[164:167], v[48:51], v[168:171], v[164:167]
    v_mfma_f32_16x16x32_bf16 v[160:163], v[36:39], v[172:175], v[160:163]
    v_mfma_f32_16x16x32_bf16 v[164:167], v[52:55], v[172:175], v[164:167]
    v_mfma_f32_16x16x32_bf16 v[160:163], v[40:43], v[176:179], v[160:163]
    v_mfma_f32_16x16x32_bf16 v[164:167], v[56:59], v[176:179], v[164:167]
    v_mfma_f32_16x16x32_bf16 v[160:163], v[44:47], v[180:183], v[160:163]
    v_mfma_f32_16x16x32_bf16 v[164:167], v[60:63], v[180:183], v[164:167]
    v_fma_f32 v88, v88, s35, -v13
    v_fma_f32 v89, v89, s35, -v13
    v_fma_f32 v90, v90, s35, -v13
    v_fma_f32 v91, v91, s35, -v13
    v_fma_f32 v92, v92, s35, -v13
    v_fma_f32 v93, v93, s35, -v13
    v_fma_f32 v94, v94, s35, -v13
    v_fma_f32 v95, v95, s35, -v13
    v_exp_f32 v88, v88
    v_exp_f32 v89, v89
    v_exp_f32 v90, v90
    v_exp_f32 v91, v91
    v_exp_f32 v92, v92
    v_exp_f32 v93, v93
    v_exp_f32 v94, v94
    v_exp_f32 v95, v95
    v_cvt_pk_bf16_f32 v140, v88, v89
    v_cvt_pk_bf16_f32 v141, v90, v91
    v_cvt_pk_bf16_f32 v142, v92, v93
    v_cvt_pk_bf16_f32 v143, v94, v95
    v_add_f32 v14, v14, v88
    v_add_f32 v12, v12, v89
    v_add_f32 v14, v14, v90
    v_add_f32 v12, v12, v91
    v_add_f32 v14, v14, v92
    v_add_f32 v12, v12, v93
    v_add_f32 v14, v14, v94
    v_add_f32 v12, v12, v95
    v_fma_f32 v96, v96, s35, -v13
    v_fma_f32 v97, v97, s35, -v13
    v_fma_f32 v98, v98, s35, -v13
    v_fma_f32 v99, v99, s35, -v13
    v_fma_f32 v100, v100, s35, -v13
    v_fma_f32 v101, v101, s35, -v13
    v_fma_f32 v102, v102, s35, -v13
    v_fma_f32 v103, v103, s35, -v13
    v_exp_f32 v96, v96
    v_exp_f32 v97, v97
    v_exp_f32 v98, v98
    v_exp_f32 v99, v99
    v_exp_f32 v100, v100
    v_exp_f32 v101, v101
    v_exp_f32 v102, v102
    v_exp_f32 v103, v103
    v_cvt_pk_bf16_f32 v144, v96, v97
    v_cvt_pk_bf16_f32 v145, v98, v99
    v_cvt_pk_bf16_f32 v146, v100, v101
    v_cvt_pk_bf16_f32 v147, v102, v103
    v_add_f32 v14, v14, v96
    v_add_f32 v12, v12, v97
    v_add_f32 v14, v14, v98
    v_add_f32 v12, v12, v99
    v_add_f32 v14, v14, v100
    v_add_f32 v12, v12, v101
    v_add_f32 v14, v14, v102
    v_add_f32 v12, v12, v103
    v_cndmask_b32 v168, 0, v136, s[88:89]
    v_cndmask_b32 v169, 0, v137, s[88:89]
    v_cndmask_b32 v170, 0, v138, s[88:89]
    v_cndmask_b32 v171, 0, v139, s[88:89]
    v_cndmask_b32 v172, 0, v136, s[90:91]
    v_cndmask_b32 v173, 0, v137, s[90:91]
    v_cndmask_b32 v174, 0, v138, s[90:91]
    v_cndmask_b32 v175, 0, v139, s[90:91]
    v_cndmask_b32 v176, 0, v136, s[92:93]
    v_cndmask_b32 v177, 0, v137, s[92:93]
    v_cndmask_b32 v178, 0, v138, s[92:93]
    v_cndmask_b32 v179, 0, v139, s[92:93]
    v_cndmask_b32 v180, 0, v136, s[94:95]
    v_cndmask_b32 v181, 0, v137, s[94:95]
    v_cndmask_b32 v182, 0, v138, s[94:95]
    v_cndmask_b32 v183, 0, v139, s[94:95]
    s_waitcnt vmcnt(25)
    ds_read_b64_tr_b16 v[32:33], v5 offset:16896
    ds_read_b64_tr_b16 v[34:35], v5 offset:17408
    ds_read_b64_tr_b16 v[36:37], v5 offset:16928
    ds_read_b64_tr_b16 v[38:39], v5 offset:17440
    ds_read_b64_tr_b16 v[40:41], v5 offset:16960
    ds_read_b64_tr_b16 v[42:43], v5 offset:17472
    ds_read_b64_tr_b16 v[44:45], v5 offset:16992
    ds_read_b64_tr_b16 v[46:47], v5 offset:17504
    ds_read_b64_tr_b16 v[48:49], v5 offset:17024
    ds_read_b64_tr_b16 v[50:51], v5 offset:17536
    ds_read_b64_tr_b16 v[52:53], v5 offset:17056
    ds_read_b64_tr_b16 v[54:55], v5 offset:17568
    ds_read_b64_tr_b16 v[56:57], v5 offset:17088
    ds_read_b64_tr_b16 v[58:59], v5 offset:17600
    ds_read_b64_tr_b16 v[60:61], v5 offset:17120
    ds_read_b64_tr_b16 v[62:63], v5 offset:17632
    s_waitcnt lgkmcnt(0)
    s_barrier
    s_add_u32 m0, s34, 16896
    s_xor_b32 s33, s32, 196608
    buffer_load_dwordx4 v3, s[28:31], s33 offen nt lds
    s_add_u32 m0, s34, 17952
    s_add_u32 s33, s33, s97
    buffer_load_dwordx4 v3, s[28:31], s33 offen nt lds
    s_add_u32 m0, s34, 19008
    s_add_u32 s33, s33, s97
    buffer_load_dwordx4 v3, s[28:31], s33 offen nt lds
    s_add_u32 m0, s34, 20064
    s_add_u32 s33, s33, s97
    buffer_load_dwordx4 v3, s[28:31], s33 offen nt lds
    s_add_u32 m0, s34, 21120
    s_add_u32 s33, s33, s97
    buffer_load_dwordx4 v3, s[28:31], s33 offen nt lds
    s_add_u32 m0, s34, 22176
    s_add_u32 s33, s33, s97
    buffer_load_dwordx4 v3, s[28:31], s33 offen nt lds
    s_add_u32 m0, s34, 23232
    s_add_u32 s33, s33, s97
    buffer_load_dwordx4 v3, s[28:31], s33 offen nt lds
    s_add_u32 m0, s34, 24288
    s_add_u32 s33, s33, s97
    buffer_load_dwordx4 v3, s[28:31], s33 offen nt lds
    v_mfma_f32_16x16x32_bf16 v[160:163], v[32:35], v[168:171], v[160:163]
    v_mfma_f32_16x16x32_bf16 v[164:167], v[48:51], v[168:171], v[164:167]
    v_mfma_f32_16x16x32_bf16 v[160:163], v[36:39], v[172:175], v[160:163]
    v_mfma_f32_16x16x32_bf16 v[164:167], v[52:55], v[172:175], v[164:167]
    v_mfma_f32_16x16x32_bf16 v[160:163], v[40:43], v[176:179], v[160:163]
    v_mfma_f32_16x16x32_bf16 v[164:167], v[56:59], v[176:179], v[164:167]
    v_mfma_f32_16x16x32_bf16 v[160:163], v[44:47], v[180:183], v[160:163]
    v_mfma_f32_16x16x32_bf16 v[164:167], v[60:63], v[180:183], v[164:167]
    v_fma_f32 v104, v104, s35, -v13
    v_fma_f32 v105, v105, s35, -v13
    v_fma_f32 v106, v106, s35, -v13
    v_fma_f32 v107, v107, s35, -v13
    v_fma_f32 v108, v108, s35, -v13
    v_fma_f32 v109, v109, s35, -v13
    v_fma_f32 v110, v110, s35, -v13
    v_fma_f32 v111, v111, s35, -v13
    v_exp_f32 v104, v104
    v_exp_f32 v105, v105
    v_exp_f32 v106, v106
    v_exp_f32 v107, v107
    v_exp_f32 v108, v108
    v_exp_f32 v109, v109
    v_exp_f32 v110, v110
    v_exp_f32 v111, v111
    v_cvt_pk_bf16_f32 v148, v104, v105
    v_cvt_pk_bf16_f32 v149, v106, v107
    v_cvt_pk_bf16_f32 v150, v108, v109
    v_cvt_pk_bf16_f32 v151, v110, v111
    v_add_f32 v14, v14, v104
    v_add_f32 v12, v12, v105
    v_add_f32 v14, v14, v106
    v_add_f32 v12, v12, v107
    v_add_f32 v14, v14, v108
    v_add_f32 v12, v12, v109
    v_add_f32 v14, v14, v110
    v_add_f32 v12, v12, v111
    v_fma_f32 v112, v112, s35, -v13
    v_fma_f32 v113, v113, s35, -v13
    v_fma_f32 v114, v114, s35, -v13
    v_fma_f32 v115, v115, s35, -v13
    v_fma_f32 v116, v116, s35, -v13
    v_fma_f32 v117, v117, s35, -v13
    v_fma_f32 v118, v118, s35, -v13
    v_fma_f32 v119, v119, s35, -v13
    v_exp_f32 v112, v112
    v_exp_f32 v113, v113
    v_exp_f32 v114, v114
    v_exp_f32 v115, v115
    v_exp_f32 v116, v116
    v_exp_f32 v117, v117
    v_exp_f32 v118, v118
    v_exp_f32 v119, v119
    v_cvt_pk_bf16_f32 v152, v112, v113
    v_cvt_pk_bf16_f32 v153, v114, v115
    v_cvt_pk_bf16_f32 v154, v116, v117
    v_cvt_pk_bf16_f32 v155, v118, v119
    v_add_f32 v14, v14, v112
    v_add_f32 v12, v12, v113
    v_add_f32 v14, v14, v114
    v_add_f32 v12, v12, v115
    v_add_f32 v14, v14, v116
    v_add_f32 v12, v12, v117
    v_add_f32 v14, v14, v118
    v_add_f32 v12, v12, v119
    v_cndmask_b32 v168, 0, v140, s[88:89]
    v_cndmask_b32 v169, 0, v141, s[88:89]
    v_cndmask_b32 v170, 0, v142, s[88:89]
    v_cndmask_b32 v171, 0, v143, s[88:89]
    v_cndmask_b32 v172, 0, v140, s[90:91]
    v_cndmask_b32 v173, 0, v141, s[90:91]
    v_cndmask_b32 v174, 0, v142, s[90:91]
    v_cndmask_b32 v175, 0, v143, s[90:91]
    v_cndmask_b32 v176, 0, v140, s[92:93]
    v_cndmask_b32 v177, 0, v141, s[92:93]
    v_cndmask_b32 v178, 0, v142, s[92:93]
    v_cndmask_b32 v179, 0, v143, s[92:93]
    v_cndmask_b32 v180, 0, v140, s[94:95]
    v_cndmask_b32 v181, 0, v141, s[94:95]
    v_cndmask_b32 v182, 0, v142, s[94:95]
    v_cndmask_b32 v183, 0, v143, s[94:95]
    s_waitcnt vmcnt(25)
    ds_read_b64_tr_b16 v[32:33], v5 offset:25344
    ds_read_b64_tr_b16 v[34:35], v5 offset:25856
    ds_read_b64_tr_b16 v[36:37], v5 offset:25376
    ds_read_b64_tr_b16 v[38:39], v5 offset:25888
    ds_read_b64_tr_b16 v[40:41], v5 offset:25408
    ds_read_b64_tr_b16 v[42:43], v5 offset:25920
    ds_read_b64_tr_b16 v[44:45], v5 offset:25440
    ds_read_b64_tr_b16 v[46:47], v5 offset:25952
    ds_read_b64_tr_b16 v[48:49], v5 offset:25472
    ds_read_b64_tr_b16 v[50:51], v5 offset:25984
    ds_read_b64_tr_b16 v[52:53], v5 offset:25504
    ds_read_b64_tr_b16 v[54:55], v5 offset:26016
    ds_read_b64_tr_b16 v[56:57], v5 offset:25536
    ds_read_b64_tr_b16 v[58:59], v5 offset:26048
    ds_read_b64_tr_b16 v[60:61], v5 offset:25568
    ds_read_b64_tr_b16 v[62:63], v5 offset:26080
    s_waitcnt lgkmcnt(0)
    s_barrier
    s_add_u32 m0, s34, 25344
    s_xor_b32 s33, s32, 229376
    buffer_load_dwordx4 v3, s[28:31], s33 offen nt lds
    s_add_u32 m0, s34, 26400
    s_add_u32 s33, s33, s97
    buffer_load_dwordx4 v3, s[28:31], s33 offen nt lds
    s_add_u32 m0, s34, 27456
    s_add_u32 s33, s33, s97
    buffer_load_dwordx4 v3, s[28:31], s33 offen nt lds
    s_add_u32 m0, s34, 28512
    s_add_u32 s33, s33, s97
    buffer_load_dwordx4 v3, s[28:31], s33 offen nt lds
    s_add_u32 m0, s34, 29568
    s_add_u32 s33, s33, s97
    buffer_load_dwordx4 v3, s[28:31], s33 offen nt lds
    s_add_u32 m0, s34, 30624
    s_add_u32 s33, s33, s97
    buffer_load_dwordx4 v3, s[28:31], s33 offen nt lds
    s_add_u32 m0, s34, 31680
    s_add_u32 s33, s33, s97
    buffer_load_dwordx4 v3, s[28:31], s33 offen nt lds
    s_add_u32 m0, s34, 32736
    s_add_u32 s33, s33, s97
    buffer_load_dwordx4 v3, s[28:31], s33 offen nt lds
    v_mfma_f32_16x16x32_bf16 v[160:163], v[32:35], v[168:171], v[160:163]
    v_mfma_f32_16x16x32_bf16 v[164:167], v[48:51], v[168:171], v[164:167]
    v_mfma_f32_16x16x32_bf16 v[160:163], v[36:39], v[172:175], v[160:163]
    v_mfma_f32_16x16x32_bf16 v[164:167], v[52:55], v[172:175], v[164:167]
    v_mfma_f32_16x16x32_bf16 v[160:163], v[40:43], v[176:179], v[160:163]
    v_mfma_f32_16x16x32_bf16 v[164:167], v[56:59], v[176:179], v[164:167]
    v_mfma_f32_16x16x32_bf16 v[160:163], v[44:47], v[180:183], v[160:163]
    v_mfma_f32_16x16x32_bf16 v[164:167], v[60:63], v[180:183], v[164:167]
    v_fma_f32 v120, v120, s35, -v13
    v_fma_f32 v121, v121, s35, -v13
    v_fma_f32 v122, v122, s35, -v13
    v_fma_f32 v123, v123, s35, -v13
    v_fma_f32 v124, v124, s35, -v13
    v_fma_f32 v125, v125, s35, -v13
    v_fma_f32 v126, v126, s35, -v13
    v_fma_f32 v127, v127, s35, -v13
    v_exp_f32 v120, v120
    v_exp_f32 v121, v121
    v_exp_f32 v122, v122
    v_exp_f32 v123, v123
    v_exp_f32 v124, v124
    v_exp_f32 v125, v125
    v_exp_f32 v126, v126
    v_exp_f32 v127, v127
    v_cvt_pk_bf16_f32 v156, v120, v121
    v_cvt_pk_bf16_f32 v157, v122, v123
    v_cvt_pk_bf16_f32 v158, v124, v125
    v_cvt_pk_bf16_f32 v159, v126, v127
    v_add_f32 v14, v14, v120
    v_add_f32 v12, v12, v121
    v_add_f32 v14, v14, v122
    v_add_f32 v12, v12, v123
    v_add_f32 v14, v14, v124
    v_add_f32 v12, v12, v125
    v_add_f32 v14, v14, v126
    v_add_f32 v12, v12, v127
    v_add_f32 v14, v14, v12
    v_mov_b32 v6, v14
    s_nop 1
    v_permlane32_swap_b32 v6, v14
    v_add_f32 v14, v14, v6
    v_mov_b32 v6, v14
    s_nop 1
    v_permlane16_swap_b32 v6, v14
    v_add_f32 v14, v14, v6
    v_mov_b32 v200, v13
    v_mov_b32 v201, v14
    s_mov_b32 exec_lo, 0x000f000f
    s_mov_b32 exec_hi, 0x000f000f
    ds_write_b64 v208, v[200:201] offset:2112
    s_mov_b64 exec, -1
    v_cndmask_b32 v168, 0, v144, s[88:89]
    v_cndmask_b32 v169, 0, v145, s[88:89]
    v_cndmask_b32 v170, 0, v146, s[88:89]
    v_cndmask_b32 v171, 0, v147, s[88:89]
    v_cndmask_b32 v172, 0, v144, s[90:91]
    v_cndmask_b32 v173, 0, v145, s[90:91]
    v_cndmask_b32 v174, 0, v146, s[90:91]
    v_cndmask_b32 v175, 0, v147, s[90:91]
    v_cndmask_b32 v176, 0, v144, s[92:93]
    v_cndmask_b32 v177, 0, v145, s[92:93]
    v_cndmask_b32 v178, 0, v146, s[92:93]
    v_cndmask_b32 v179, 0, v147, s[92:93]
    v_cndmask_b32 v180, 0, v144, s[94:95]
    v_cndmask_b32 v181, 0, v145, s[94:95]
    v_cndmask_b32 v182, 0, v146, s[94:95]
    v_cndmask_b32 v183, 0, v147, s[94:95]
    s_waitcnt vmcnt(25)
    ds_read_b64_tr_b16 v[32:33], v5 offset:0
    ds_read_b64_tr_b16 v[34:35], v5 offset:512
    ds_read_b64_tr_b16 v[36:37], v5 offset:32
    ds_read_b64_tr_b16 v[38:39], v5 offset:544
    ds_read_b64_tr_b16 v[40:41], v5 offset:64
    ds_read_b64_tr_b16 v[42:43], v5 offset:576
    ds_read_b64_tr_b16 v[44:45], v5 offset:96
    ds_read_b64_tr_b16 v[46:47], v5 offset:608
    ds_read_b64_tr_b16 v[48:49], v5 offset:128
    ds_read_b64_tr_b16 v[50:51], v5 offset:640
    ds_read_b64_tr_b16 v[52:53], v5 offset:160
    ds_read_b64_tr_b16 v[54:55], v5 offset:672
    ds_read_b64_tr_b16 v[56:57], v5 offset:192
    ds_read_b64_tr_b16 v[58:59], v5 offset:704
    ds_read_b64_tr_b16 v[60:61], v5 offset:224
    ds_read_b64_tr_b16 v[62:63], v5 offset:736
    s_waitcnt lgkmcnt(14)
    v_mfma_f32_16x16x32_bf16 v[160:163], v[32:35], v[168:171], v[160:163]
    s_waitcnt lgkmcnt(12)
    v_mfma_f32_16x16x32_bf16 v[160:163], v[36:39], v[172:175], v[160:163]
    s_waitcnt lgkmcnt(10)
    v_mfma_f32_16x16x32_bf16 v[160:163], v[40:43], v[176:179], v[160:163]
    s_waitcnt lgkmcnt(8)
    v_mfma_f32_16x16x32_bf16 v[160:163], v[44:47], v[180:183], v[160:163]
    s_waitcnt lgkmcnt(6)
    v_mfma_f32_16x16x32_bf16 v[164:167], v[48:51], v[168:171], v[164:167]
    s_waitcnt lgkmcnt(4)
    v_mfma_f32_16x16x32_bf16 v[164:167], v[52:55], v[172:175], v[164:167]
    s_waitcnt lgkmcnt(2)
    v_mfma_f32_16x16x32_bf16 v[164:167], v[56:59], v[176:179], v[164:167]
    s_waitcnt lgkmcnt(0)
    v_mfma_f32_16x16x32_bf16 v[164:167], v[60:63], v[180:183], v[164:167]
    v_cndmask_b32 v168, 0, v148, s[88:89]
    v_cndmask_b32 v169, 0, v149, s[88:89]
    v_cndmask_b32 v170, 0, v150, s[88:89]
    v_cndmask_b32 v171, 0, v151, s[88:89]
    v_cndmask_b32 v172, 0, v148, s[90:91]
    v_cndmask_b32 v173, 0, v149, s[90:91]
    v_cndmask_b32 v174, 0, v150, s[90:91]
    v_cndmask_b32 v175, 0, v151, s[90:91]
    v_cndmask_b32 v176, 0, v148, s[92:93]
    v_cndmask_b32 v177, 0, v149, s[92:93]
    v_cndmask_b32 v178, 0, v150, s[92:93]
    v_cndmask_b32 v179, 0, v151, s[92:93]
    v_cndmask_b32 v180, 0, v148, s[94:95]
    v_cndmask_b32 v181, 0, v149, s[94:95]
    v_cndmask_b32 v182, 0, v150, s[94:95]
    v_cndmask_b32 v183, 0, v151, s[94:95]
    s_waitcnt vmcnt(16)
    v_cmp_ne_u32 vcc, v210, v211
    s_nop 4
    s_cmp_eq_u64 vcc, 0
    s_cselect_b32 s22, 1, 0
    s_cbranch_scc0 L_nopfin
    s_cmp_eq_u32 s3, s37
    s_cbranch_scc0 L_nopfin
    global_load_dword v209, v197, s[20:21]
    global_load_dword v209, v198, s[20:21]
    global_load_dword v209, v199, s[20:21]
L_nopfin:
    ds_read_b64_tr_b16 v[32:33], v5 offset:8448
    ds_read_b64_tr_b16 v[34:35], v5 offset:8960
    ds_read_b64_tr_b16 v[36:37], v5 offset:8480
    ds_read_b64_tr_b16 v[38:39], v5 offset:8992
    ds_read_b64_tr_b16 v[40:41], v5 offset:8512
    ds_read_b64_tr_b16 v[42:43], v5 offset:9024
    ds_read_b64_tr_b16 v[44:45], v5 offset:8544
    ds_read_b64_tr_b16 v[46:47], v5 offset:9056
    ds_read_b64_tr_b16 v[48:49], v5 offset:8576
    ds_read_b64_tr_b16 v[50:51], v5 offset:9088
    ds_read_b64_tr_b16 v[52:53], v5 offset:8608
    ds_read_b64_tr_b16 v[54:55], v5 offset:9120
    ds_read_b64_tr_b16 v[56:57], v5 offset:8640
    ds_read_b64_tr_b16 v[58:59], v5 offset:9152
    ds_read_b64_tr_b16 v[60:61], v5 offset:8672
    ds_read_b64_tr_b16 v[62:63], v5 offset:9184
    s_waitcnt lgkmcnt(14)
    v_mfma_f32_16x16x32_bf16 v[160:163], v[32:35], v[168:171], v[160:163]
    s_waitcnt lgkmcnt(12)
    v_mfma_f32_16x16x32_bf16 v[160:163], v[36:39], v[172:175], v[160:163]
    s_waitcnt lgkmcnt(10)
    v_mfma_f32_16x16x32_bf16 v[160:163], v[40:43], v[176:179], v[160:163]
    s_waitcnt lgkmcnt(8)
    v_mfma_f32_16x16x32_bf16 v[160:163], v[44:47], v[180:183], v[160:163]
    s_waitcnt lgkmcnt(6)
    v_mfma_f32_16x16x32_bf16 v[164:167], v[48:51], v[168:171], v[164:167]
    s_waitcnt lgkmcnt(4)
    v_mfma_f32_16x16x32_bf16 v[164:167], v[52:55], v[172:175], v[164:167]
    s_waitcnt lgkmcnt(2)
    v_mfma_f32_16x16x32_bf16 v[164:167], v[56:59], v[176:179], v[164:167]
    s_waitcnt lgkmcnt(0)
    v_mfma_f32_16x16x32_bf16 v[164:167], v[60:63], v[180:183], v[164:167]
    v_cndmask_b32 v168, 0, v152, s[88:89]
    v_cndmask_b32 v169, 0, v153, s[88:89]
    v_cndmask_b32 v170, 0, v154, s[88:89]
    v_cndmask_b32 v171, 0, v155, s[88:89]
    v_cndmask_b32 v172, 0, v152, s[90:91]
    v_cndmask_b32 v173, 0, v153, s[90:91]
    v_cndmask_b32 v174, 0, v154, s[90:91]
    v_cndmask_b32 v175, 0, v155, s[90:91]
    v_cndmask_b32 v176, 0, v152, s[92:93]
    v_cndmask_b32 v177, 0, v153, s[92:93]
    v_cndmask_b32 v178, 0, v154, s[92:93]
    v_cndmask_b32 v179, 0, v155, s[92:93]
    v_cndmask_b32 v180, 0, v152, s[94:95]
    v_cndmask_b32 v181, 0, v153, s[94:95]
    v_cndmask_b32 v182, 0, v154, s[94:95]
    v_cndmask_b32 v183, 0, v155, s[94:95]
    s_waitcnt vmcnt(8)
    ds_read_b64_tr_b16 v[32:33], v5 offset:16896
    ds_read_b64_tr_b16 v[34:35], v5 offset:17408
    ds_read_b64_tr_b16 v[36:37], v5 offset:16928
    ds_read_b64_tr_b16 v[38:39], v5 offset:17440
    ds_read_b64_tr_b16 v[40:41], v5 offset:16960
    ds_read_b64_tr_b16 v[42:43], v5 offset:17472
    ds_read_b64_tr_b16 v[44:45], v5 offset:16992
    ds_read_b64_tr_b16 v[46:47], v5 offset:17504
    ds_read_b64_tr_b16 v[48:49], v5 offset:17024
    ds_read_b64_tr_b16 v[50:51], v5 offset:17536
    ds_read_b64_tr_b16 v[52:53], v5 offset:17056
    ds_read_b64_tr_b16 v[54:55], v5 offset:17568
    ds_read_b64_tr_b16 v[56:57], v5 offset:17088
    ds_read_b64_tr_b16 v[58:59], v5 offset:17600
    ds_read_b64_tr_b16 v[60:61], v5 offset:17120
    ds_read_b64_tr_b16 v[62:63], v5 offset:17632
    s_waitcnt lgkmcnt(14)
    v_mfma_f32_16x16x32_bf16 v[160:163], v[32:35], v[168:171], v[160:163]
    s_waitcnt lgkmcnt(12)
    v_mfma_f32_16x16x32_bf16 v[160:163], v[36:39], v[172:175], v[160:163]
    s_waitcnt lgkmcnt(10)
    v_mfma_f32_16x16x32_bf16 v[160:163], v[40:43], v[176:179], v[160:163]
    s_waitcnt lgkmcnt(8)
    v_mfma_f32_16x16x32_bf16 v[160:163], v[44:47], v[180:183], v[160:163]
    s_waitcnt lgkmcnt(6)
    v_mfma_f32_16x16x32_bf16 v[164:167], v[48:51], v[168:171], v[164:167]
    s_waitcnt lgkmcnt(4)
    v_mfma_f32_16x16x32_bf16 v[164:167], v[52:55], v[172:175], v[164:167]
    s_waitcnt lgkmcnt(2)
    v_mfma_f32_16x16x32_bf16 v[164:167], v[56:59], v[176:179], v[164:167]
    s_waitcnt lgkmcnt(0)
    v_mfma_f32_16x16x32_bf16 v[164:167], v[60:63], v[180:183], v[164:167]
    s_waitcnt lgkmcnt(0)
    s_barrier
    ds_read_b64 v[64:65], v194 offset:0
    ds_read_b64 v[66:67], v194 offset:2240
    ds_read_b64 v[68:69], v194 offset:4480
    ds_read_b64 v[70:71], v194 offset:6720
    v_lshlrev_b32 v200, 16, v11
    v_and_b32 v202, 0xffff0000, v11
    s_waitcnt lgkmcnt(0)
    v_max3_f32 v201, v10, v64, v66
    v_max3_f32 v201, v201, v68, v70
    v_sub_f32 v204, v64, v201
    v_sub_f32 v205, v66, v201
    v_sub_f32 v206, v68, v201
    v_sub_f32 v207, v70, v201
    v_sub_f32 v10, v10, v201
    v_exp_f32 v204, v204
    v_exp_f32 v205, v205
    v_exp_f32 v206, v206
    v_exp_f32 v207, v207
    v_exp_f32 v10, v10
    s_nop 0
    v_mov_b32 v203, v10
    v_fmac_f32 v203, v204, v65
    v_fmac_f32 v203, v205, v67
    v_fmac_f32 v203, v206, v69
    v_fmac_f32 v203, v207, v71
    v_rcp_f32 v7, v203
    v_log_f32 v8, v203
    v_mov_b32 v203, s99
    v_mul_f32 v10, v10, v7
    v_mul_f32 v204, v204, v7
    v_mul_f32 v205, v205, v7
    v_mul_f32 v206, v206, v7
    v_mul_f32 v207, v207, v7
    v_add_f32 v201, v201, v8
    v_mul_f32 v200, v200, v10
    v_mul_f32 v202, v202, v10
    v_cndmask_b32 v168, 0, v156, s[88:89]
    v_cndmask_b32 v169, 0, v157, s[88:89]
    v_cndmask_b32 v170, 0, v158, s[88:89]
    v_cndmask_b32 v171, 0, v159, s[88:89]
    v_cndmask_b32 v172, 0, v156, s[90:91]
    v_cndmask_b32 v173, 0, v157, s[90:91]
    v_cndmask_b32 v174, 0, v158, s[90:91]
    v_cndmask_b32 v175, 0, v159, s[90:91]
    v_cndmask_b32 v176, 0, v156, s[92:93]
    v_cndmask_b32 v177, 0, v157, s[92:93]
    v_cndmask_b32 v178, 0, v158, s[92:93]
    v_cndmask_b32 v179, 0, v159, s[92:93]
    v_cndmask_b32 v180, 0, v156, s[94:95]
    v_cndmask_b32 v181, 0, v157, s[94:95]
    v_cndmask_b32 v182, 0, v158, s[94:95]
    v_cndmask_b32 v183, 0, v159, s[94:95]
    s_waitcnt vmcnt(0)
    ds_read_b64_tr_b16 v[32:33], v5 offset:25344
    ds_read_b64_tr_b16 v[34:35], v5 offset:25856
    ds_read_b64_tr_b16 v[36:37], v5 offset:25376
    ds_read_b64_tr_b16 v[38:39], v5 offset:25888
    ds_read_b64_tr_b16 v[40:41], v5 offset:25408
    ds_read_b64_tr_b16 v[42:43], v5 offset:25920
    ds_read_b64_tr_b16 v[44:45], v5 offset:25440
    ds_read_b64_tr_b16 v[46:47], v5 offset:25952
    ds_read_b64_tr_b16 v[48:49], v5 offset:25472
    ds_read_b64_tr_b16 v[50:51], v5 offset:25984
    ds_read_b64_tr_b16 v[52:53], v5 offset:25504
    ds_read_b64_tr_b16 v[54:55], v5 offset:26016
    ds_read_b64_tr_b16 v[56:57], v5 offset:25536
    ds_read_b64_tr_b16 v[58:59], v5 offset:26048
    ds_read_b64_tr_b16 v[60:61], v5 offset:25568
    ds_read_b64_tr_b16 v[62:63], v5 offset:26080
    s_waitcnt lgkmcnt(14)
    v_mfma_f32_16x16x32_bf16 v[160:163], v[32:35], v[168:171], v[160:163]
    s_waitcnt lgkmcnt(12)
    v_mfma_f32_16x16x32_bf16 v[160:163], v[36:39], v[172:175], v[160:163]
    s_waitcnt lgkmcnt(10)
    v_mfma_f32_16x16x32_bf16 v[160:163], v[40:43], v[176:179], v[160:163]
    s_waitcnt lgkmcnt(8)
    v_mfma_f32_16x16x32_bf16 v[160:163], v[44:47], v[180:183], v[160:163]
    s_waitcnt lgkmcnt(6)
    v_mfma_f32_16x16x32_bf16 v[164:167], v[48:51], v[168:171], v[164:167]
    s_waitcnt lgkmcnt(4)
    v_mfma_f32_16x16x32_bf16 v[164:167], v[52:55], v[172:175], v[164:167]
    s_waitcnt lgkmcnt(2)
    v_mfma_f32_16x16x32_bf16 v[164:167], v[56:59], v[176:179], v[164:167]
    s_waitcnt lgkmcnt(0)
    v_mfma_f32_16x16x32_bf16 v[164:167], v[60:63], v[180:183], v[164:167]
    ds_write_b128 v192, v[160:163] offset:0
    s_nop 6
    ds_write_b128 v192, v[164:167] offset:256
    s_waitcnt lgkmcnt(0)
    s_barrier
    ds_read_b64 v[32:33], v193 offset:0
    ds_read_b64 v[34:35], v193 offset:2240
    ds_read_b64 v[36:37], v193 offset:4480
    ds_read_b64 v[38:39], v193 offset:6720
    s_waitcnt lgkmcnt(3)
    v_fmac_f32 v200, v204, v32
    v_fmac_f32 v202, v204, v33
    s_waitcnt lgkmcnt(2)
    v_fmac_f32 v200, v205, v34
    v_fmac_f32 v202, v205, v35
    s_waitcnt lgkmcnt(1)
    v_fmac_f32 v200, v206, v36
    v_fmac_f32 v202, v206, v37
    s_waitcnt lgkmcnt(0)
    v_fmac_f32 v200, v207, v38
    v_fmac_f32 v202, v207, v39
    s_cmp_eq_u32 s3, s37
    s_cbranch_scc1 L_consumer
    s_cmp_eq_u32 s22, 1
    s_cbranch_scc0 L_far
    global_store_dwordx4 v195, v[200:203], s[20:21]
    s_endpgm
L_far:
    global_store_dwordx4 v195, v[200:203], s[20:21] sc1
    s_endpgm
L_consumer:
L_poll:
    global_load_dwordx4 v[80:83], v197, s[20:21] sc1
    global_load_dwordx4 v[84:87], v198, s[20:21] sc1
    global_load_dwordx4 v[88:91], v199, s[20:21] sc1
    s_waitcnt vmcnt(0)
    v_readfirstlane_b32 s38, v81
    v_readfirstlane_b32 s39, v85
    v_readfirstlane_b32 s40, v89
    v_xor_b32 v7, s99, v83
    v_xor_b32 v8, s99, v87
    v_xor_b32 v9, s99, v91
    v_or3_b32 v7, v7, v8, v9
    v_xor_b32 v6, s38, v81
    v_xor_b32 v8, s39, v85
    v_xor_b32 v9, s40, v89
    v_or3_b32 v6, v6, v8, v9
    v_or_b32 v7, v7, v6
    v_cmp_ne_u32 vcc, 0, v7
    s_sub_u32 s23, s23, 1
    s_cbranch_scc1 L_end
    s_cbranch_vccnz L_poll
    v_max3_f32 v13, v201, v81, v85
    v_max_f32 v13, v13, v89
    v_sub_f32 v201, v201, v13
    v_sub_f32 v81, v81, v13
    v_sub_f32 v85, v85, v13
    v_sub_f32 v89, v89, v13
    v_exp_f32 v201, v201
    v_exp_f32 v81, v81
    v_exp_f32 v85, v85
    v_exp_f32 v89, v89
    v_add_f32 v9, v201, v81
    v_add_f32 v6, v85, v89
    v_mul_f32 v7, v201, v200
    v_mul_f32 v8, v201, v202
    v_add_f32 v9, v9, v6
    v_rcp_f32 v9, v9
    v_fmac_f32 v7, v81, v80
    v_fmac_f32 v8, v81, v82
    v_fmac_f32 v7, v85, v84
    v_fmac_f32 v8, v85, v86
    v_fmac_f32 v7, v89, v88
    v_fmac_f32 v8, v89, v90
    v_mul_f32 v7, v7, v9
    v_mul_f32 v8, v8, v9
    v_cvt_pk_bf16_f32 v7, v7, v8
    global_store_dword v196, v7, s[16:17]
    s_lshl_b32 s38, s36, 7
    s_add_u32 s38, s38, 1048576
    v_mov_b32 v6, s38
    v_mov_b32 v8, s99
    s_cmp_eq_u32 s37, 0
    s_cbranch_scc0 L_end
    s_mov_b64 exec, 1
    global_store_dword v6, v8, s[20:21]
L_end:
    s_endpgm
.section .rodata,"a"
.p2align 6
.amdhsa_kernel standalone__tree_speculative_verify_tree_attention_over_candidate_token_tree__decode_kernel
  .amdhsa_next_free_vgpr 216
  .amdhsa_next_free_sgpr 100
  .amdhsa_accum_offset 216
  .amdhsa_group_segment_fixed_size 0
  .amdhsa_kernarg_size 72
  .amdhsa_user_sgpr_count 2
  .amdhsa_user_sgpr_kernarg_segment_ptr 1
  .amdhsa_system_sgpr_workgroup_id_x 1
.end_amdhsa_kernel
```
